```python
import torch

def _softmax(x, axis=-1):
    return torch.softmax(x, dim=axis)
def _gelu(x):
    return torch.nn.functional.gelu(x, approximate="tanh")
def _silu(x):
    return torch.nn.functional.silu(x)
def _sigmoid(x):
    return torch.sigmoid(x)
def _layernorm(x, axis=-1, eps=1e-5):
    m = x.mean(dim=axis, keepdim=True)
    v = x.var(dim=axis, keepdim=True, unbiased=False)
    return (x - m) / torch.sqrt(v + eps)
def _scatter_add(tgt, idx, src, axis=0):
    return tgt.clone().index_add_(axis, idx, src)
def _segment_sum(src, seg, n):
    out = torch.zeros((n,) + src.shape[1:], dtype=src.dtype)
    return out.index_add_(0, seg, src)
def _pad(x, pw):
    flat = tuple(v for pair in reversed(pw) for v in pair)
    return torch.nn.functional.pad(x, flat)

kernel_name = 'standalone__rezero__sampling'

def setup_inputs():

    _w = (lambda a: (lambda t: t.to(torch.bfloat16) if t.is_floating_point() else t)(torch.as_tensor(a)))
    B, S, D = 1024, 8, 640
    return {
        "x": _w((lambda *s: torch.randn(*s, dtype=torch.bfloat16) * 0.05)(B, S, D)),
        "fx": _w((lambda *s: torch.randn(*s, dtype=torch.bfloat16) * 0.8)(B, S, D)),
        "alpha": _w((lambda *s: torch.randn(*s, dtype=torch.bfloat16) * 0.8)(1) * 0.1),
    }

def reference(x, fx, alpha):
    return x + alpha * fx
```

```asm
; @launch grid=(256,1,1) block=(512,1,1) lds=0
.amdgcn_target "amdgcn-amd-amdhsa--gfx950"
.text
.p2align 13
.globl standalone__rezero__sampling_kernel
.p2align 8
.type standalone__rezero__sampling_kernel,@function
standalone__rezero__sampling_kernel:
    s_load_dwordx8 s[4:11], s[0:1], 0
    s_cmp_ge_u32 s2, 256
    s_cbranch_scc1 L_done
    s_and_b32 s13, s2, 7
    s_lshr_b32 s2, s2, 3
    s_lshl_b32 s13, s13, 5
    s_add_u32 s2, s2, s13
    s_mul_i32 s12, s2, 40
    v_lshrrev_b32 v1, 6, v0
    v_add_u32 v1, s2, v1
    v_and_b32 v1, 7, v1
    v_mul_u32_u24 v1, 5, v1
    v_add_u32 v1, s12, v1
    v_bfe_u32 v2, v0, 3, 3
    v_and_b32 v0, 7, v0
    v_lshlrev_b32 v2, 11, v2
    v_lshl_add_u32 v0, v0, 4, v2
    v_lshl_add_u32 v0, v1, 7, v0
    s_movk_i32 s13, 14336
    s_mov_b32 s3, 0xffff0000
    v_lshrrev_b32 v2, 4, v1
    v_mad_u32_u24 v58, v2, s13, v0
    v_add_u32 v1, 1, v1
    v_lshrrev_b32 v2, 4, v1
    v_mad_u32_u24 v59, v2, s13, v0
    v_add_u32 v1, 1, v1
    v_lshrrev_b32 v2, 4, v1
    v_mad_u32_u24 v60, v2, s13, v0
    v_add_u32 v1, 1, v1
    v_lshrrev_b32 v2, 4, v1
    v_mad_u32_u24 v61, v2, s13, v0
    v_add_u32 v1, 1, v1
    v_lshrrev_b32 v2, 4, v1
    v_mad_u32_u24 v62, v2, s13, v0
    s_waitcnt lgkmcnt(0)
    s_load_dword s14, s[8:9], 0
    global_load_dwordx4 v[22:25], v58, s[6:7] offset:0 nt
    global_load_dwordx4 v[18:21], v58, s[4:5] offset:0 nt
    global_load_dwordx4 v[30:33], v59, s[6:7] offset:128 nt
    global_load_dwordx4 v[26:29], v59, s[4:5] offset:128 nt
    global_load_dwordx4 v[38:41], v60, s[6:7] offset:256 nt
    global_load_dwordx4 v[34:37], v60, s[4:5] offset:256 nt
    global_load_dwordx4 v[46:49], v61, s[6:7] offset:384 nt
    global_load_dwordx4 v[42:45], v61, s[4:5] offset:384 nt
    global_load_dwordx4 v[54:57], v62, s[6:7] offset:512 nt
    global_load_dwordx4 v[50:53], v62, s[4:5] offset:512 nt
    s_bitcmp1_b32 s8, 1
    s_cselect_b32 s15, 0, 16
    s_waitcnt lgkmcnt(0)
    s_lshl_b32 s16, s14, s15
    s_and_b32 s16, s16, s3
    s_mov_b32 s17, s16
    s_waitcnt vmcnt(8)
    v_lshlrev_b32 v2, 16, v22
    v_and_b32 v3, s3, v22
    v_lshlrev_b32 v6, 16, v23
    v_and_b32 v7, s3, v23
    v_lshlrev_b32 v10, 16, v24
    v_and_b32 v11, s3, v24
    v_lshlrev_b32 v14, 16, v25
    v_and_b32 v15, s3, v25
    v_pk_mul_f32 v[2:3], s[16:17], v[2:3]
    v_pk_mul_f32 v[6:7], s[16:17], v[6:7]
    v_pk_mul_f32 v[10:11], s[16:17], v[10:11]
    v_pk_mul_f32 v[14:15], s[16:17], v[14:15]
    v_lshlrev_b32 v4, 16, v18
    v_and_b32 v5, s3, v18
    v_lshlrev_b32 v8, 16, v19
    v_and_b32 v9, s3, v19
    v_lshlrev_b32 v12, 16, v20
    v_and_b32 v13, s3, v20
    v_lshlrev_b32 v16, 16, v21
    v_and_b32 v17, s3, v21
    v_cvt_pk_bf16_f32 v2, 0, v2
    v_cvt_pk_bf16_f32 v3, 0, v3
    v_cvt_pk_bf16_f32 v6, 0, v6
    v_cvt_pk_bf16_f32 v7, 0, v7
    v_cvt_pk_bf16_f32 v10, 0, v10
    v_cvt_pk_bf16_f32 v11, 0, v11
    v_cvt_pk_bf16_f32 v14, 0, v14
    v_cvt_pk_bf16_f32 v15, 0, v15
    v_pk_add_f32 v[2:3], v[4:5], v[2:3]
    v_pk_add_f32 v[6:7], v[8:9], v[6:7]
    v_pk_add_f32 v[10:11], v[12:13], v[10:11]
    v_pk_add_f32 v[14:15], v[16:17], v[14:15]
    v_cvt_pk_bf16_f32 v18, v2, v3
    v_cvt_pk_bf16_f32 v19, v6, v7
    v_cvt_pk_bf16_f32 v20, v10, v11
    v_cvt_pk_bf16_f32 v21, v14, v15
    s_waitcnt vmcnt(6)
    v_lshlrev_b32 v2, 16, v30
    v_and_b32 v3, s3, v30
    v_lshlrev_b32 v6, 16, v31
    v_and_b32 v7, s3, v31
    v_lshlrev_b32 v10, 16, v32
    v_and_b32 v11, s3, v32
    v_lshlrev_b32 v14, 16, v33
    v_and_b32 v15, s3, v33
    v_pk_mul_f32 v[2:3], s[16:17], v[2:3]
    v_pk_mul_f32 v[6:7], s[16:17], v[6:7]
    v_pk_mul_f32 v[10:11], s[16:17], v[10:11]
    v_pk_mul_f32 v[14:15], s[16:17], v[14:15]
    v_lshlrev_b32 v4, 16, v26
    v_and_b32 v5, s3, v26
    v_lshlrev_b32 v8, 16, v27
    v_and_b32 v9, s3, v27
    v_lshlrev_b32 v12, 16, v28
    v_and_b32 v13, s3, v28
    v_lshlrev_b32 v16, 16, v29
    v_and_b32 v17, s3, v29
    v_cvt_pk_bf16_f32 v2, 0, v2
    v_cvt_pk_bf16_f32 v3, 0, v3
    v_cvt_pk_bf16_f32 v6, 0, v6
    v_cvt_pk_bf16_f32 v7, 0, v7
    v_cvt_pk_bf16_f32 v10, 0, v10
    v_cvt_pk_bf16_f32 v11, 0, v11
    v_cvt_pk_bf16_f32 v14, 0, v14
    v_cvt_pk_bf16_f32 v15, 0, v15
    v_pk_add_f32 v[2:3], v[4:5], v[2:3]
    v_pk_add_f32 v[6:7], v[8:9], v[6:7]
    v_pk_add_f32 v[10:11], v[12:13], v[10:11]
    v_pk_add_f32 v[14:15], v[16:17], v[14:15]
    v_cvt_pk_bf16_f32 v26, v2, v3
    v_cvt_pk_bf16_f32 v27, v6, v7
    v_cvt_pk_bf16_f32 v28, v10, v11
    v_cvt_pk_bf16_f32 v29, v14, v15
    s_waitcnt vmcnt(4)
    v_lshlrev_b32 v2, 16, v38
    v_and_b32 v3, s3, v38
    v_lshlrev_b32 v6, 16, v39
    v_and_b32 v7, s3, v39
    v_lshlrev_b32 v10, 16, v40
    v_and_b32 v11, s3, v40
    v_lshlrev_b32 v14, 16, v41
    v_and_b32 v15, s3, v41
    v_pk_mul_f32 v[2:3], s[16:17], v[2:3]
    v_pk_mul_f32 v[6:7], s[16:17], v[6:7]
    v_pk_mul_f32 v[10:11], s[16:17], v[10:11]
    v_pk_mul_f32 v[14:15], s[16:17], v[14:15]
    v_lshlrev_b32 v4, 16, v34
    v_and_b32 v5, s3, v34
    v_lshlrev_b32 v8, 16, v35
    v_and_b32 v9, s3, v35
    v_lshlrev_b32 v12, 16, v36
    v_and_b32 v13, s3, v36
    v_lshlrev_b32 v16, 16, v37
    v_and_b32 v17, s3, v37
    v_cvt_pk_bf16_f32 v2, 0, v2
    v_cvt_pk_bf16_f32 v3, 0, v3
    v_cvt_pk_bf16_f32 v6, 0, v6
    v_cvt_pk_bf16_f32 v7, 0, v7
    v_cvt_pk_bf16_f32 v10, 0, v10
    v_cvt_pk_bf16_f32 v11, 0, v11
    v_cvt_pk_bf16_f32 v14, 0, v14
    v_cvt_pk_bf16_f32 v15, 0, v15
    v_pk_add_f32 v[2:3], v[4:5], v[2:3]
    v_pk_add_f32 v[6:7], v[8:9], v[6:7]
    v_pk_add_f32 v[10:11], v[12:13], v[10:11]
    v_pk_add_f32 v[14:15], v[16:17], v[14:15]
    v_cvt_pk_bf16_f32 v34, v2, v3
    v_cvt_pk_bf16_f32 v35, v6, v7
    v_cvt_pk_bf16_f32 v36, v10, v11
    v_cvt_pk_bf16_f32 v37, v14, v15
    s_waitcnt vmcnt(2)
    v_lshlrev_b32 v2, 16, v46
    v_and_b32 v3, s3, v46
    v_lshlrev_b32 v6, 16, v47
    v_and_b32 v7, s3, v47
    v_lshlrev_b32 v10, 16, v48
    v_and_b32 v11, s3, v48
    v_lshlrev_b32 v14, 16, v49
    v_and_b32 v15, s3, v49
    v_pk_mul_f32 v[2:3], s[16:17], v[2:3]
    v_pk_mul_f32 v[6:7], s[16:17], v[6:7]
    v_pk_mul_f32 v[10:11], s[16:17], v[10:11]
    v_pk_mul_f32 v[14:15], s[16:17], v[14:15]
    v_lshlrev_b32 v4, 16, v42
    v_and_b32 v5, s3, v42
    v_lshlrev_b32 v8, 16, v43
    v_and_b32 v9, s3, v43
    v_lshlrev_b32 v12, 16, v44
    v_and_b32 v13, s3, v44
    v_lshlrev_b32 v16, 16, v45
    v_and_b32 v17, s3, v45
    v_cvt_pk_bf16_f32 v2, 0, v2
    v_cvt_pk_bf16_f32 v3, 0, v3
    v_cvt_pk_bf16_f32 v6, 0, v6
    v_cvt_pk_bf16_f32 v7, 0, v7
    v_cvt_pk_bf16_f32 v10, 0, v10
    v_cvt_pk_bf16_f32 v11, 0, v11
    v_cvt_pk_bf16_f32 v14, 0, v14
    v_cvt_pk_bf16_f32 v15, 0, v15
    v_pk_add_f32 v[2:3], v[4:5], v[2:3]
    v_pk_add_f32 v[6:7], v[8:9], v[6:7]
    v_pk_add_f32 v[10:11], v[12:13], v[10:11]
    v_pk_add_f32 v[14:15], v[16:17], v[14:15]
    v_cvt_pk_bf16_f32 v42, v2, v3
    v_cvt_pk_bf16_f32 v43, v6, v7
    v_cvt_pk_bf16_f32 v44, v10, v11
    v_cvt_pk_bf16_f32 v45, v14, v15
    s_waitcnt vmcnt(0)
    s_barrier
    global_store_dwordx4 v58, v[18:21], s[10:11] offset:0 nt
    global_store_dwordx4 v59, v[26:29], s[10:11] offset:128 nt
    global_store_dwordx4 v60, v[34:37], s[10:11] offset:256 nt
    global_store_dwordx4 v61, v[42:45], s[10:11] offset:384 nt
    v_lshlrev_b32 v2, 16, v54
    v_and_b32 v3, s3, v54
    v_lshlrev_b32 v6, 16, v55
    v_and_b32 v7, s3, v55
    v_lshlrev_b32 v10, 16, v56
    v_and_b32 v11, s3, v56
    v_lshlrev_b32 v14, 16, v57
    v_and_b32 v15, s3, v57
    v_pk_mul_f32 v[2:3], s[16:17], v[2:3]
    v_pk_mul_f32 v[6:7], s[16:17], v[6:7]
    v_pk_mul_f32 v[10:11], s[16:17], v[10:11]
    v_pk_mul_f32 v[14:15], s[16:17], v[14:15]
    v_lshlrev_b32 v4, 16, v50
    v_and_b32 v5, s3, v50
    v_lshlrev_b32 v8, 16, v51
    v_and_b32 v9, s3, v51
    v_lshlrev_b32 v12, 16, v52
    v_and_b32 v13, s3, v52
    v_lshlrev_b32 v16, 16, v53
    v_and_b32 v17, s3, v53
    v_cvt_pk_bf16_f32 v2, 0, v2
    v_cvt_pk_bf16_f32 v3, 0, v3
    v_cvt_pk_bf16_f32 v6, 0, v6
    v_cvt_pk_bf16_f32 v7, 0, v7
    v_cvt_pk_bf16_f32 v10, 0, v10
    v_cvt_pk_bf16_f32 v11, 0, v11
    v_cvt_pk_bf16_f32 v14, 0, v14
    v_cvt_pk_bf16_f32 v15, 0, v15
    v_pk_add_f32 v[2:3], v[4:5], v[2:3]
    v_pk_add_f32 v[6:7], v[8:9], v[6:7]
    v_pk_add_f32 v[10:11], v[12:13], v[10:11]
    v_pk_add_f32 v[14:15], v[16:17], v[14:15]
    v_cvt_pk_bf16_f32 v50, v2, v3
    v_cvt_pk_bf16_f32 v51, v6, v7
    v_cvt_pk_bf16_f32 v52, v10, v11
    v_cvt_pk_bf16_f32 v53, v14, v15
    global_store_dwordx4 v62, v[50:53], s[10:11] offset:512 nt
L_done:
    s_endpgm
.section .rodata,"a"
.p2align 6
.amdhsa_kernel standalone__rezero__sampling_kernel
  .amdhsa_next_free_vgpr 63
  .amdhsa_next_free_sgpr 18
  .amdhsa_accum_offset 64
  .amdhsa_group_segment_fixed_size 0
  .amdhsa_kernarg_size 48
  .amdhsa_user_sgpr_count 2
  .amdhsa_user_sgpr_kernarg_segment_ptr 1
  .amdhsa_system_sgpr_workgroup_id_x 1
  .amdhsa_float_denorm_mode_32 3
  .amdhsa_float_denorm_mode_16_64 3
.end_amdhsa_kernel
```
